```python
import torch

def _softmax(x, axis=-1):
    return torch.softmax(x, dim=axis)
def _gelu(x):
    return torch.nn.functional.gelu(x, approximate="tanh")
def _silu(x):
    return torch.nn.functional.silu(x)
def _sigmoid(x):
    return torch.sigmoid(x)
def _layernorm(x, axis=-1, eps=1e-5):
    m = x.mean(dim=axis, keepdim=True)
    v = x.var(dim=axis, keepdim=True, unbiased=False)
    return (x - m) / torch.sqrt(v + eps)
def _scatter_add(tgt, idx, src, axis=0):
    return tgt.clone().index_add_(axis, idx, src)
def _segment_sum(src, seg, n):
    out = torch.zeros((n,) + src.shape[1:], dtype=src.dtype)
    return out.index_add_(0, seg, src)
def _pad(x, pw):
    flat = tuple(v for pair in reversed(pw) for v in pair)
    return torch.nn.functional.pad(x, flat)

kernel_name = 'recurrent_scan__sliding_block_cached__geglu_ffn__decode'

def setup_inputs():

    _w = (lambda a: (lambda t: t.to(torch.bfloat16) if t.is_floating_point() else t)(torch.as_tensor(a)))
    def _A_setup():
        B, Sq, D = 1, 1, 448
        Hq, Hkv, Sk, Dh = 16, 8, 32768, 256
        assert Hq % Hkv == 0, (Hq, Hkv)
        return {
            "x": _w((lambda *s: torch.randn(*s, dtype=torch.bfloat16) * 0.05)(B, Sq, D)),
            "k_cache": _w((lambda *s: torch.randn(*s, dtype=torch.bfloat16) * 1.6)(B, Hkv, Sk, Dh)),
            "v_cache": _w((lambda *s: torch.randn(*s, dtype=torch.bfloat16) * 0.2)(B, Hkv, Sk, Dh)),
            "wq": _w((lambda *s: torch.randn(*s, dtype=torch.bfloat16) * 1.6)(D, Hq * Dh) * (D ** -0.5)),
            "wo": _w((lambda *s: torch.randn(*s, dtype=torch.bfloat16) * 0.2)(Hq * Dh, D) * ((Hq * Dh) ** -0.5)),
        }
    _A_in = _A_setup()

    def _B_setup():
        B, S, D, F = 1, 1, 448, 1792
        return {
            "x": _w((lambda *s: torch.randn(*s, dtype=torch.bfloat16) * 0.05)(B, S, D)),
            "w_gate": _w((lambda *s: torch.randn(*s, dtype=torch.bfloat16) * 0.1)(D, F)),
            "w_up": _w((lambda *s: torch.randn(*s, dtype=torch.bfloat16) * 0.1)(D, F)),
            "w_down": _w((lambda *s: torch.randn(*s, dtype=torch.bfloat16) * 0.1)(F, D)),
        }
    _B_in = _B_setup()

    return {
        "A_x": _A_in["x"],
        "A_k_cache": _A_in["k_cache"],
        "A_v_cache": _A_in["v_cache"],
        "A_wq": _A_in["wq"],
        "A_wo": _A_in["wo"],
        "B_x": _B_in["x"],
        "B_w_gate": _B_in["w_gate"],
        "B_w_up": _B_in["w_up"],
        "B_w_down": _B_in["w_down"],
    }

def reference(A_x, A_k_cache, A_v_cache, A_wq, A_wo, B_x, B_w_gate, B_w_up, B_w_down):
    def _A_ref(x, k_cache, v_cache, wq, wo):
        B, Sq, D = x.shape
        Hq, Dh = 16, 256
        Hkv, Sk = k_cache.shape[1], k_cache.shape[2]
        W = min(4096, max(256, Sk // 4))
        rep = Hq // Hkv
        q = (lambda x, *d: x.permute(*d))((x @ wq).reshape(B, Sq, Hq, Dh), 0, 2, 1, 3)
        k = (lambda x, n, axis: torch.repeat_interleave(x, n, dim=axis))(k_cache[:, :, Sk - W:, :], rep, axis=1)
        v = (lambda x, n, axis: torch.repeat_interleave(x, n, dim=axis))(v_cache[:, :, Sk - W:, :], rep, axis=1)
        scores = torch.einsum("bhqd,bhkd->bhqk", q, k) * (Dh ** -0.5)
        p = _softmax(scores, axis=-1)
        o = torch.einsum("bhqk,bhkd->bhqd", p, v)
        return (lambda x, *d: x.permute(*d))(o, 0, 2, 1, 3).reshape(B, Sq, Hq * Dh) @ wo

    def _B_ref(x, w_gate, w_up, w_down):
        return (_gelu(x @ w_gate) * (x @ w_up)) @ w_down

    x = A_x
    xn = _layernorm(x, axis=-1)
    s = _A_ref(xn, A_k_cache, A_v_cache, A_wq, A_wo)
    g = _silu(_B_ref(xn, B_w_gate, B_w_up, B_w_down))
    return x + s * g
```

```asm
; @launch grid=(256,1,1) block=(576,1,1) lds=28672
.amdgcn_target "amdgcn-amd-amdhsa--gfx950"
.text
.globl recurrent_scan__sliding_block_cached__geglu_ffn__decode_kernel
.p2align 12
.p2align 8
.type recurrent_scan__sliding_block_cached__geglu_ffn__decode_kernel,@function
recurrent_scan__sliding_block_cached__geglu_ffn__decode_kernel:
    s_load_dwordx16 s[4:19], s[0:1], 0
    s_load_dwordx8 s[20:27], s[0:1], 64
    s_cmp_ge_u32 s2, 256
    s_cbranch_scc1 L_end
    v_lshrrev_b32 v2, 6, v0
    v_and_b32 v1, 63, v0
    v_readfirstlane_b32 s30, v2
    s_and_b32 s28, s2, 7
    s_lshr_b32 s29, s2, 3
    v_lshrrev_b32 v121, 3, v1
    v_and_b32 v0, 7, v1
    v_lshlrev_b32 v122, 4, v0
    s_cmp_lg_u32 s30, 0
    s_cbranch_scc1 L_work
    s_setprio 3
    v_mov_b32 v6, 0
    v_and_b32 v7, 60, v1
    ds_write_b32 v7, v6 offset:960
    s_lshr_b32 s38, s29, 3
    s_mul_i32 s36, s38, 112
    v_mul_u32_u24 v4, 14, v121
    v_add_u32 v4, s36, v4
    s_lshl_b32 s36, s28, 10
    s_and_b32 s37, s29, 7
    s_lshl_b32 s37, s37, 7
    s_add_u32 s36, s36, s37
    v_lshlrev_b32 v3, 13, v4
    v_add3_u32 v3, v3, s36, v122
    v_min_u32 v2, 55, v1
    v_lshlrev_b32 v2, 4, v2
    s_waitcnt lgkmcnt(0)
    global_load_dwordx4 v[8:11], v2, s[4:5]
    global_load_dwordx4 v[16:19], v3, s[10:11] nt
    v_add_u32 v3, 0x2000, v3
    global_load_dwordx4 v[20:23], v3, s[10:11] nt
    v_add_u32 v3, 0x2000, v3
    global_load_dwordx4 v[24:27], v3, s[10:11] nt
    v_add_u32 v3, 0x2000, v3
    global_load_dwordx4 v[28:31], v3, s[10:11] nt
    v_add_u32 v3, 0x2000, v3
    global_load_dwordx4 v[32:35], v3, s[10:11] nt
    v_add_u32 v3, 0x2000, v3
    global_load_dwordx4 v[36:39], v3, s[10:11] nt
    v_add_u32 v3, 0x2000, v3
    global_load_dwordx4 v[40:43], v3, s[10:11] nt
    v_add_u32 v3, 0x2000, v3
    global_load_dwordx4 v[44:47], v3, s[10:11] nt
    v_add_u32 v3, 0x2000, v3
    global_load_dwordx4 v[48:51], v3, s[10:11] nt
    v_add_u32 v3, 0x2000, v3
    global_load_dwordx4 v[52:55], v3, s[10:11] nt
    v_add_u32 v3, 0x2000, v3
    global_load_dwordx4 v[56:59], v3, s[10:11] nt
    v_add_u32 v3, 0x2000, v3
    global_load_dwordx4 v[60:63], v3, s[10:11] nt
    v_add_u32 v3, 0x2000, v3
    global_load_dwordx4 v[64:67], v3, s[10:11] nt
    v_add_u32 v3, 0x2000, v3
    global_load_dwordx4 v[68:71], v3, s[10:11] nt
    s_barrier
    s_load_dword s32, s[26:27], 0
    s_branch L_comm
L_work:
    s_sub_u32 s31, s30, 1
    s_lshl_b32 s36, s28, 24
    s_lshl_b32 s37, s29, 16
    s_add_u32 s36, s36, s37
    s_lshl_b32 s37, s31, 13
    s_add_u32 s36, s36, s37
    s_add_u32 s36, s36, 14680064
    v_and_b32 v120, 3, v1
    v_lshlrev_b32 v2, 9, v120
    v_lshrrev_b32 v7, 2, v1
    v_lshl_add_u32 v2, v7, 4, v2
    v_add_u32 v2, s36, v2
    s_lshl_b32 s37, s2, 3
    s_add_u32 s37, s37, s31
    s_mul_i32 s37, s37, 2654435761
    s_lshr_b32 s37, s37, 19
    s_and_b32 s55, s37, 0x100
    s_and_b32 s54, s37, 0x1e00
    s_or_b32 s37, s54, s55
    v_xor_b32 v2, s37, v2
    s_mov_b32 s34, 0x05040100
    s_mov_b32 s35, 0x07060302
    s_mov_b32 s33, 0x3db8aa3b
    s_mov_b32 s60, 0x7060500
    s_mov_b32 s61, 0x7060501
    s_mov_b32 s62, 0x7060502
    s_mov_b32 s63, 0x7060503
    v_add_u32 v120, s60, v120
    s_lshr_b32 s53, s28, 1
    s_mul_i32 s53, s53, 7
    s_and_b32 s52, s28, 1
    s_lshl_b32 s42, s52, 2
    s_add_u32 s53, s53, s42
    s_lshr_b32 s47, s29, 3
    s_and_b32 s48, s29, 7
    s_add_u32 s42, s47, s52
    s_cmp_lt_u32 s42, 4
    s_cselect_b32 s39, -1, 0
    s_cmp_lt_u32 s31, 7
    s_cselect_b32 s39, s39, 0
    s_mul_i32 s42, s48, 56
    s_lshl_b32 s43, s31, 3
    s_add_u32 s42, s42, s43
    v_add_u32 v123, s42, v121
    s_add_u32 s43, s53, s47
    s_lshl_b32 s43, s43, 7
    v_mul_u32_u24 v4, 3584, v123
    v_add3_u32 v4, v4, s43, v122
    v_lshlrev_b32 v123, 1, v123
    v_and_b32 v3, 16, v1
    v_lshlrev_b32 v3, 7, v3
    v_and_b32 v7, 32, v1
    v_lshl_add_u32 v3, v7, 3, v3
    v_and_b32 v7, 15, v1
    v_lshl_add_u32 v3, v7, 4, v3
    v_add_u32 v3, s36, v3
    v_xor_b32 v3, s54, v3
    s_and_b32 s44, s29, 3
    s_lshr_b32 s49, s29, 2
    s_lshl_b32 s42, s28, 9
    s_and_b32 s43, s29, 1
    s_lshl_b32 s43, s43, 8
    s_add_u32 s42, s42, s43
    s_and_b32 s43, s29, 2
    s_lshl_b32 s43, s43, 6
    s_add_u32 s42, s42, s43
    s_and_b32 s43, s31, 3
    s_lshl_b32 s43, s43, 5
    s_add_u32 s42, s42, s43
    s_and_b32 s43, s31, 4
    s_add_u32 s42, s42, s43
    s_waitcnt lgkmcnt(0)
    s_barrier
    global_load_dwordx4 v[8:11], v2, s[6:7] nt
    v_xor_b32 v2, 256, v2
    global_load_dwordx4 v[12:15], v2, s[6:7] nt
    s_load_dword s32, s[26:27], 0
    v_lshrrev_b32 v5, 4, v1
    v_lshlrev_b32 v5, 3, v5
    v_and_b32 v7, 1, v121
    v_lshl_add_u32 v5, v7, 1, v5
    v_add_u32 v5, s42, v5
    s_lshl_b32 s43, s49, 7
    v_mul_u32_u24 v5, 896, v5
    v_add3_u32 v5, v5, s43, v122
    s_add_u32 s42, s53, s44
    s_lshl_b32 s42, s42, 3
    s_add_u32 s42, s42, s31
    s_lshl_b32 s42, s42, 3
    v_add_u32 v92, s42, v121
    v_mul_u32_u24 v92, 896, v92
    v_add3_u32 v92, v92, s43, v122
    s_add_u32 s42, s44, s52
    s_cmp_lt_u32 s42, 4
    s_cselect_b32 s40, -1, 0
    s_lshl_b32 s42, s28, 5
    s_and_b32 s43, s31, 1
    s_lshl_b32 s43, s43, 4
    s_add_u32 s42, s42, s43
    v_lshrrev_b32 v6, 2, v1
    v_add_u32 v6, s42, v6
    v_mul_u32_u24 v6, 2432, v6
    s_lshl_b32 s42, s29, 6
    s_add_u32 s42, s42, 262144
    v_and_b32 v7, 48, v122
    v_add3_u32 v6, v6, s42, v7
    s_mul_i32 s42, s49, 17920
    s_lshl_b32 s43, s28, 2
    s_add_u32 s43, s43, s44
    s_lshl_b32 s43, s43, 7
    s_add_u32 s42, s42, s43
    s_add_u32 s42, s42, 917504
    v_lshrrev_b32 v7, 4, v1
    v_mul_u32_u24 v7, 4480, v7
    v_and_b32 v124, 12, v1
    v_lshlrev_b32 v124, 2, v124
    v_add3_u32 v122, v7, s42, v124
    v_and_b32 v124, 1, v1
    v_lshl_add_u32 v122, v124, 6, v122
    v_mov_b32 v88, 0
    v_mov_b32 v89, 0
    v_mov_b32 v90, 0
    v_mov_b32 v91, 0
    v_and_b32 v124, 1, v1
    v_lshlrev_b32 v125, 5, v124
    s_lshl_b32 s42, s31, 2
    v_add_u32 v125, s42, v125
    v_lshlrev_b32 v124, 9, v124
    v_lshrrev_b32 v7, 2, v1
    v_lshl_add_u32 v124, v7, 4, v124
    v_xor_b32 v124, s55, v124
    s_waitcnt vmcnt(1)
    v_xor_b32 v2, 2304, v2
    global_load_dwordx4 v[16:19], v2, s[6:7] nt
    v_xor_b32 v2, 256, v2
    global_load_dwordx4 v[20:23], v2, s[6:7] nt
    s_waitcnt vmcnt(2)
    s_cmp_eq_u32 s39, 0
    s_cbranch_scc1 L_skG
    global_load_dwordx4 v[72:75], v4, s[16:17] nt
L_skG:
    s_waitcnt vmcnt(2)
    s_cmp_eq_u32 s39, 0
    s_cbranch_scc1 L_skU
    global_load_dwordx4 v[76:79], v4, s[18:19] nt
L_skU:
    s_waitcnt vmcnt(2)
    v_xor_b32 v2, 6400, v2
    global_load_dwordx4 v[24:27], v2, s[6:7] nt
    s_waitcnt vmcnt(2)
    v_xor_b32 v2, 256, v2
    global_load_dwordx4 v[28:31], v2, s[6:7] nt
    s_waitcnt vmcnt(2)
    v_xor_b32 v2, 2304, v2
    global_load_dwordx4 v[32:35], v2, s[6:7] nt
    s_waitcnt vmcnt(2)
    v_xor_b32 v2, 256, v2
    global_load_dwordx4 v[36:39], v2, s[6:7] nt
    s_waitcnt vmcnt(2)
    global_load_dwordx4 v[40:43], v3, s[8:9] nt
    s_cmp_eq_u32 s39, 0
    s_cbranch_scc1 L_gudone
    v_mov_b32 v96, 0
    v_mov_b32 v97, 1
L_xspin:
    ds_read_b32 v126, v96 offset:984
    ds_read_u16 v7, v123 offset:0
    s_waitcnt lgkmcnt(0)
    v_readfirstlane_b32 s42, v126
    s_nop 0
    s_cmp_eq_u32 s42, 0
    s_cbranch_scc1 L_xspin
    v_lshlrev_b32 v126, 16, v7
    v_dot2_f32_bf16 v104, v72, v7, 0
    v_dot2_f32_bf16 v105, v72, v126, 0
    v_dot2_f32_bf16 v106, v73, v7, 0
    v_dot2_f32_bf16 v107, v73, v126, 0
    v_dot2_f32_bf16 v108, v74, v7, 0
    v_dot2_f32_bf16 v109, v74, v126, 0
    v_dot2_f32_bf16 v110, v75, v7, 0
    v_dot2_f32_bf16 v111, v75, v126, 0
    v_dot2_f32_bf16 v112, v76, v7, 0
    v_dot2_f32_bf16 v113, v76, v126, 0
    v_dot2_f32_bf16 v114, v77, v7, 0
    v_dot2_f32_bf16 v115, v77, v126, 0
    v_dot2_f32_bf16 v116, v78, v7, 0
    v_dot2_f32_bf16 v117, v78, v126, 0
    v_dot2_f32_bf16 v118, v79, v7, 0
    v_dot2_f32_bf16 v119, v79, v126, 0
    v_and_b32 v123, 48, v1
    v_lshl_add_u32 v123, v0, 6, v123
    s_lshl_b32 s42, s31, 9
    v_add_u32 v123, s42, v123
    v_permlane32_swap_b32 v104, v108
    v_permlane32_swap_b32 v105, v109
    v_permlane32_swap_b32 v106, v110
    v_permlane32_swap_b32 v107, v111
    v_permlane32_swap_b32 v112, v116
    v_permlane32_swap_b32 v113, v117
    v_permlane32_swap_b32 v114, v118
    v_permlane32_swap_b32 v115, v119
    v_pk_add_f32 v[104:105], v[104:105], v[108:109]
    v_pk_add_f32 v[106:107], v[106:107], v[110:111]
    v_pk_add_f32 v[112:113], v[112:113], v[116:117]
    v_pk_add_f32 v[114:115], v[114:115], v[118:119]
    v_permlane16_swap_b32 v104, v106
    v_permlane16_swap_b32 v105, v107
    v_permlane16_swap_b32 v112, v114
    v_permlane16_swap_b32 v113, v115
    v_pk_add_f32 v[104:105], v[104:105], v[106:107]
    v_pk_add_f32 v[112:113], v[112:113], v[114:115]
    s_nop 0
    v_add_f32_dpp v76, v104, v104 row_ror:8 row_mask:0xf bank_mask:0xf
    v_add_f32_dpp v77, v105, v105 row_ror:8 row_mask:0xf bank_mask:0xf
    v_add_f32_dpp v78, v112, v112 row_ror:8 row_mask:0xf bank_mask:0xf
    v_add_f32_dpp v79, v113, v113 row_ror:8 row_mask:0xf bank_mask:0xf
    ds_write_b128 v123, v[76:79] offset:3584
    s_mov_b64 exec, 1
    ds_add_u32 v96, v97 offset:992
    s_mov_b64 exec, -1
L_gudone:
    s_waitcnt vmcnt(2)
    v_xor_b32 v3, 512, v3
    global_load_dwordx4 v[44:47], v3, s[8:9] nt
    s_waitcnt vmcnt(2)
    v_xor_b32 v3, 1536, v3
    global_load_dwordx4 v[48:51], v3, s[8:9] nt
    s_waitcnt vmcnt(2)
    v_xor_b32 v3, 512, v3
    global_load_dwordx4 v[52:55], v3, s[8:9] nt
    v_mov_b32 v2, 0
    v_xor_b32 v7, 0x100, v124
    s_waitcnt lgkmcnt(0)
    s_add_u32 s32, s32, 2654435769
    s_bfe_u32 s56, s32, 0x80000
    s_bfe_u32 s57, s32, 0x80008
    s_bfe_u32 s58, s32, 0x80010
    s_bfe_u32 s59, s32, 0x80018
L_qspin:
    ds_read_b32 v126, v2 offset:1008
    ds_read_b128 v[96:99], v124 offset:1024
    ds_read_b128 v[100:103], v7 offset:1024
    s_waitcnt lgkmcnt(0)
    v_readfirstlane_b32 s46, v126
    s_nop 0
    s_cmp_eq_u32 s46, 0
    s_cbranch_scc1 L_qspin
    v_mfma_f32_4x4x4_16b_bf16 v[104:107], v[8:9], v[96:97], 0
    v_mfma_f32_4x4x4_16b_bf16 v[108:111], v[16:17], v[96:97], 0
    v_mfma_f32_4x4x4_16b_bf16 v[112:115], v[24:25], v[96:97], 0
    v_mfma_f32_4x4x4_16b_bf16 v[116:119], v[32:33], v[96:97], 0
    v_mfma_f32_4x4x4_16b_bf16 v[104:107], v[10:11], v[98:99], v[104:107]
    v_mfma_f32_4x4x4_16b_bf16 v[108:111], v[18:19], v[98:99], v[108:111]
    v_mfma_f32_4x4x4_16b_bf16 v[112:115], v[26:27], v[98:99], v[112:115]
    v_mfma_f32_4x4x4_16b_bf16 v[116:119], v[34:35], v[98:99], v[116:119]
    v_mfma_f32_4x4x4_16b_bf16 v[104:107], v[12:13], v[100:101], v[104:107]
    v_mfma_f32_4x4x4_16b_bf16 v[108:111], v[20:21], v[100:101], v[108:111]
    v_mfma_f32_4x4x4_16b_bf16 v[112:115], v[28:29], v[100:101], v[112:115]
    v_mfma_f32_4x4x4_16b_bf16 v[116:119], v[36:37], v[100:101], v[116:119]
    v_mfma_f32_4x4x4_16b_bf16 v[104:107], v[14:15], v[102:103], v[104:107]
    v_mfma_f32_4x4x4_16b_bf16 v[108:111], v[22:23], v[102:103], v[108:111]
    v_mfma_f32_4x4x4_16b_bf16 v[112:115], v[30:31], v[102:103], v[112:115]
    v_mfma_f32_4x4x4_16b_bf16 v[116:119], v[38:39], v[102:103], v[116:119]
    v_mov_b32 v7, 1
    v_mov_b32 v126, 0
    s_nop 1
    v_permlane32_swap_b32 v104, v112
    v_permlane32_swap_b32 v105, v113
    v_permlane32_swap_b32 v106, v114
    v_permlane32_swap_b32 v107, v115
    v_permlane32_swap_b32 v108, v116
    v_permlane32_swap_b32 v109, v117
    v_permlane32_swap_b32 v110, v118
    v_permlane32_swap_b32 v111, v119
    v_pk_add_f32 v[104:105], v[104:105], v[112:113]
    v_pk_add_f32 v[106:107], v[106:107], v[114:115]
    v_pk_add_f32 v[108:109], v[108:109], v[116:117]
    v_pk_add_f32 v[110:111], v[110:111], v[118:119]
    s_nop 0
    v_permlane16_swap_b32 v104, v108
    v_permlane16_swap_b32 v105, v109
    v_permlane16_swap_b32 v106, v110
    v_permlane16_swap_b32 v107, v111
    v_pk_add_f32 v[104:105], v[104:105], v[108:109]
    v_pk_add_f32 v[106:107], v[106:107], v[110:111]
    s_nop 0
    v_add_f32_dpp v104, v104, v104 row_ror:8 row_mask:0xf bank_mask:0xf
    v_add_f32_dpp v105, v105, v105 row_ror:8 row_mask:0xf bank_mask:0xf
    v_add_f32_dpp v106, v106, v106 row_ror:8 row_mask:0xf bank_mask:0xf
    v_add_f32_dpp v107, v107, v107 row_ror:8 row_mask:0xf bank_mask:0xf
    v_add_f32_dpp v104, v104, v104 row_ror:4 row_mask:0xf bank_mask:0xf
    v_add_f32_dpp v105, v105, v105 row_ror:4 row_mask:0xf bank_mask:0xf
    v_add_f32_dpp v106, v106, v106 row_ror:4 row_mask:0xf bank_mask:0xf
    v_add_f32_dpp v107, v107, v107 row_ror:4 row_mask:0xf bank_mask:0xf
    v_cvt_pk_bf16_f32 v108, v104, v105
    v_cvt_pk_bf16_f32 v109, v106, v107
    v_lshlrev_b32 v104, 16, v108
    v_and_b32 v105, 0xffff0000, v108
    v_lshlrev_b32 v106, 16, v109
    v_and_b32 v107, 0xffff0000, v109
    v_max3_f32 v2, v104, v105, v106
    v_max_f32 v2, v2, v107
    v_mov_b32 v108, v2
    s_nop 1
    v_permlane16_swap_b32 v2, v108
    v_max_f32 v2, v2, v108
    v_mov_b32 v108, v2
    s_nop 1
    v_permlane32_swap_b32 v2, v108
    v_max_f32 v2, v2, v108
    v_sub_f32 v104, v104, v2
    v_sub_f32 v105, v105, v2
    v_sub_f32 v106, v106, v2
    v_sub_f32 v107, v107, v2
    ds_write_b32 v125, v2 offset:2048
    v_mul_f32 v104, s33, v104
    v_mul_f32 v105, s33, v105
    v_mul_f32 v106, s33, v106
    v_mul_f32 v107, s33, v107
    v_exp_f32 v104, v104
    v_exp_f32 v105, v105
    v_exp_f32 v106, v106
    v_exp_f32 v107, v107
    s_nop 0
    v_pk_add_f32 v[108:109], v[104:105], v[106:107]
    v_add_f32 v108, v108, v109
    v_mov_b32 v109, v108
    s_nop 1
    v_permlane16_swap_b32 v108, v109
    v_add_f32 v108, v108, v109
    v_mov_b32 v109, v108
    s_nop 1
    v_permlane32_swap_b32 v108, v109
    v_add_f32 v108, v108, v109
    ds_write_b32 v125, v108 offset:2112
    s_mov_b64 exec, 1
    ds_add_u32 v126, v7 offset:1016
    s_mov_b64 exec, -1
    s_waitcnt vmcnt(2)
    v_xor_b32 v3, 5632, v3
    global_load_dwordx4 v[56:59], v3, s[8:9] nt
    s_waitcnt vmcnt(2)
    v_xor_b32 v3, 512, v3
    global_load_dwordx4 v[60:63], v3, s[8:9] nt
    s_waitcnt vmcnt(2)
    v_xor_b32 v3, 1536, v3
    global_load_dwordx4 v[64:67], v3, s[8:9] nt
    v_xor_b32 v3, 512, v3
    global_load_dwordx4 v[68:71], v3, s[8:9] nt
    v_and_b32 v7, 32, v125
    v_mov_b32 v72, 0
    v_mov_b32 v73, 1
L_mspin:
    ds_read_b32 v126, v72 offset:1016
    ds_read_b128 v[108:111], v7 offset:2048
    ds_read_b128 v[112:115], v7 offset:2064
    s_waitcnt lgkmcnt(0)
    v_readfirstlane_b32 s42, v126
    s_nop 0
    s_cmp_lg_u32 s42, 8
    s_cbranch_scc1 L_mspin
    v_max3_f32 v126, v108, v109, v110
    v_max3_f32 v126, v126, v111, v112
    v_max3_f32 v126, v126, v113, v114
    v_max_f32 v126, v126, v115
    v_sub_f32 v126, v2, v126
    v_mul_f32 v126, s33, v126
    v_exp_f32 v126, v126
    s_nop 0
    v_mul_f32 v104, v104, v126
    v_mul_f32 v105, v105, v126
    v_mul_f32 v106, v106, v126
    v_mul_f32 v107, v107, v126
    v_cvt_pk_bf16_f32 v116, v104, v105
    v_cvt_pk_bf16_f32 v117, v106, v107
    v_mov_b32 v118, v116
    v_mov_b32 v119, v117
    s_lshl_b32 s42, s31, 11
    v_lshl_add_u32 v7, v1, 4, s42
    v_permlane32_swap_b32 v116, v118
    v_permlane32_swap_b32 v117, v119
    s_lshl_b32 s42, s31, 10
    v_lshl_add_u32 v124, v1, 4, s42
    s_lshl_b32 s42, s31, 5
    v_lshl_add_u32 v125, v121, 2, s42
    v_lshrrev_b32 v123, 4, v1
    v_lshlrev_b32 v123, 1, v123
    v_and_b32 v126, 3, v1
    v_lshl_add_u32 v123, v126, 3, v123
    v_add_u32 v123, s42, v123
    v_lshrrev_b32 v76, 1, v125
    s_and_b32 s43, s31, 4
    v_mov_b32 v77, s43
    s_and_b32 s42, s31, 4
    s_add_u32 s42, s42, s44
    s_lshl_b32 s42, s42, 2
    s_and_b32 s43, s31, 3
    s_add_u32 s42, s42, s43
    s_lshl_b32 s43, s28, 5
    s_add_u32 s42, s42, s43
    s_mul_i32 s42, s42, 2432
    s_add_u32 s42, s42, 262144
    v_lshl_add_u32 v4, v1, 4, s42
    v_and_b32 v74, 60, v1
    v_lshlrev_b32 v74, 1, v74
    v_lshlrev_b32 v75, 3, v1
    s_lshl_b32 s42, s31, 9
    v_add_u32 v2, s42, v75
    s_waitcnt vmcnt(4)
    v_perm_b32 v96, v44, v40, s34
    v_perm_b32 v97, v52, v48, s34
    v_perm_b32 v98, v44, v40, s35
    v_perm_b32 v99, v52, v48, s35
    v_mfma_f32_4x4x4_16b_bf16 v[8:11], v[116:117], v[96:97], 0
    v_perm_b32 v100, v45, v41, s34
    v_perm_b32 v101, v53, v49, s34
    v_mfma_f32_4x4x4_16b_bf16 v[12:15], v[116:117], v[98:99], 0
    v_perm_b32 v102, v45, v41, s35
    v_perm_b32 v103, v53, v49, s35
    v_mfma_f32_4x4x4_16b_bf16 v[16:19], v[116:117], v[100:101], 0
    v_perm_b32 v96, v46, v42, s34
    v_perm_b32 v97, v54, v50, s34
    v_mfma_f32_4x4x4_16b_bf16 v[20:23], v[116:117], v[102:103], 0
    v_perm_b32 v98, v46, v42, s35
    v_perm_b32 v99, v54, v50, s35
    v_mfma_f32_4x4x4_16b_bf16 v[24:27], v[116:117], v[96:97], 0
    v_perm_b32 v100, v47, v43, s34
    v_perm_b32 v101, v55, v51, s34
    v_mfma_f32_4x4x4_16b_bf16 v[28:31], v[116:117], v[98:99], 0
    v_perm_b32 v102, v47, v43, s35
    v_perm_b32 v103, v55, v51, s35
    v_mfma_f32_4x4x4_16b_bf16 v[32:35], v[116:117], v[100:101], 0
    s_nop 0
    v_mfma_f32_4x4x4_16b_bf16 v[36:39], v[116:117], v[102:103], 0
    v_mov_b32 v3, s32
    s_cmp_ge_u32 s29, 28
    s_waitcnt vmcnt(2)
    s_cbranch_scc1 L_w0
    global_load_dwordx4 v[80:83], v5, s[12:13] offset:0 nt
    global_load_dwordx4 v[84:87], v5, s[12:13] offset:896 nt
    s_cmp_eq_u32 s40, 0
    s_cbranch_scc1 L_w2
    global_load_dwordx4 v[88:91], v92, s[20:21] nt
    v_perm_b32 v40, v60, v56, s34
    v_perm_b32 v42, v60, v56, s35
    v_perm_b32 v44, v61, v57, s34
    v_perm_b32 v46, v61, v57, s35
    v_perm_b32 v48, v62, v58, s34
    v_perm_b32 v50, v62, v58, s35
    v_perm_b32 v52, v63, v59, s34
    v_perm_b32 v54, v63, v59, s35
    s_waitcnt vmcnt(3)
L_wd:
    v_perm_b32 v41, v68, v64, s34
    v_perm_b32 v43, v68, v64, s35
    v_perm_b32 v45, v69, v65, s34
    v_mfma_f32_4x4x4_16b_bf16 v[8:11], v[118:119], v[40:41], v[8:11]
    v_perm_b32 v47, v69, v65, s35
    v_mfma_f32_4x4x4_16b_bf16 v[12:15], v[118:119], v[42:43], v[12:15]
    v_perm_b32 v49, v70, v66, s34
    v_mfma_f32_4x4x4_16b_bf16 v[16:19], v[118:119], v[44:45], v[16:19]
    v_perm_b32 v51, v70, v66, s35
    v_mfma_f32_4x4x4_16b_bf16 v[20:23], v[118:119], v[46:47], v[20:23]
    v_perm_b32 v53, v71, v67, s34
    v_mfma_f32_4x4x4_16b_bf16 v[24:27], v[118:119], v[48:49], v[24:27]
    v_perm_b32 v55, v71, v67, s35
    v_mfma_f32_4x4x4_16b_bf16 v[28:31], v[118:119], v[50:51], v[28:31]
    v_permlane16_swap_b32 v8, v9
    v_mfma_f32_4x4x4_16b_bf16 v[32:35], v[118:119], v[52:53], v[32:35]
    v_permlane16_swap_b32 v12, v13
    v_mfma_f32_4x4x4_16b_bf16 v[36:39], v[118:119], v[54:55], v[36:39]
    v_permlane16_swap_b32 v16, v17
    v_permlane16_swap_b32 v20, v21
    v_add_f32 v96, v8, v9
    v_add_f32 v97, v12, v13
    v_add_f32 v98, v16, v17
    v_add_f32 v99, v20, v21
    v_permlane16_swap_b32 v24, v25
    ds_write_b128 v7, v[96:99] offset:8192
    v_permlane16_swap_b32 v28, v29
    v_permlane16_swap_b32 v32, v33
    v_permlane16_swap_b32 v36, v37
    v_add_f32 v100, v24, v25
    v_add_f32 v101, v28, v29
    v_add_f32 v102, v32, v33
    v_add_f32 v103, v36, v37
    ds_write_b128 v7, v[100:103] offset:9216
    s_mov_b64 exec, 1
    ds_add_u32 v77, v73 offset:968
    s_mov_b64 exec, -1
    s_cmp_ge_u32 s31, 2
    s_cbranch_scc1 L_D
L_ospin0:
    ds_read_b32 v56, v72 offset:968
    ds_read_b128 v[8:11], v124 offset:8192
    ds_read_b128 v[12:15], v124 offset:10240
    ds_read_b128 v[16:19], v124 offset:12288
    ds_read_b128 v[20:23], v124 offset:14336
    s_waitcnt lgkmcnt(2)
    v_readfirstlane_b32 s42, v56
    v_pk_add_f32 v[8:9], v[8:9], v[12:13]
    v_pk_add_f32 v[10:11], v[10:11], v[14:15]
    s_cmp_lg_u32 s42, 4
    s_cbranch_scc1 L_ospin0
    s_waitcnt lgkmcnt(0)
    v_pk_add_f32 v[16:17], v[16:17], v[20:21]
    v_pk_add_f32 v[18:19], v[18:19], v[22:23]
    v_pk_add_f32 v[8:9], v[8:9], v[16:17]
    v_pk_add_f32 v[10:11], v[10:11], v[18:19]
L_ospin1:
    ds_read_b32 v56, v72 offset:972
    ds_read_b128 v[24:27], v124 offset:16384
    ds_read_b128 v[28:31], v124 offset:18432
    ds_read_b128 v[32:35], v124 offset:20480
    ds_read_b128 v[36:39], v124 offset:22528
    s_waitcnt lgkmcnt(2)
    v_readfirstlane_b32 s42, v56
    v_pk_add_f32 v[24:25], v[24:25], v[28:29]
    v_pk_add_f32 v[26:27], v[26:27], v[30:31]
    s_cmp_lg_u32 s42, 4
    s_cbranch_scc1 L_ospin1
    s_waitcnt lgkmcnt(0)
    v_pk_add_f32 v[32:33], v[32:33], v[36:37]
    v_pk_add_f32 v[34:35], v[34:35], v[38:39]
    v_pk_add_f32 v[24:25], v[24:25], v[32:33]
    v_pk_add_f32 v[26:27], v[26:27], v[34:35]
    v_pk_add_f32 v[8:9], v[8:9], v[24:25]
    v_pk_add_f32 v[10:11], v[10:11], v[26:27]
    v_perm_b32 v60, v8, v3, s60
    v_perm_b32 v61, v9, v3, s61
    v_perm_b32 v62, v10, v3, s62
    v_perm_b32 v63, v11, v3, s63
    s_cmp_lg_u32 s46, 2
    s_cbranch_scc1 L_ps0
    global_store_dwordx4 v6, v[60:63], s[26:27]
    s_branch L_opub
L_ps0:
    global_store_dwordx4 v6, v[60:63], s[26:27] sc1
L_opub:
    s_mov_b64 exec, 1
    ds_add_u32 v72, v73 offset:996
    s_mov_b64 exec, -1
L_D:
    s_cmp_ge_u32 s29, 28
    s_cbranch_scc1 L_wend
    s_mov_b32 s4, 0xff
    s_mov_b32 s41, 20000
    s_mov_b32 s44, 0x33333333
    s_mov_b32 s45, 0x33333333
    s_mov_b32 vcc_lo, 0x55555555
    s_mov_b32 vcc_hi, 0x55555555
L_pspin:
    ds_read_b32 v8, v72 offset:996
    s_waitcnt lgkmcnt(0)
    v_readfirstlane_b32 s42, v8
    s_nop 0
    s_cmp_lg_u32 s42, 2
    s_cbranch_scc1 L_pspin
    global_load_dwordx4 v[40:43], v4, s[26:27] offset:0 sc1
    global_load_dwordx4 v[44:47], v4, s[26:27] offset:1024 sc1
    ds_read_b32 v9, v72 offset:1000
    ds_read_b64 v[48:49], v74 offset:2176
    ds_read_u16 v118, v76 offset:2560
    s_waitcnt vmcnt(2)
    v_perm_b32 v16, v84, v80, s34
    v_perm_b32 v17, v84, v80, s35
    v_perm_b32 v18, v85, v81, s34
    v_perm_b32 v19, v85, v81, s35
    v_perm_b32 v20, v86, v82, s34
    v_perm_b32 v21, v86, v82, s35
    v_perm_b32 v22, v87, v83, s34
    v_perm_b32 v23, v87, v83, s35
L_ochk:
    s_waitcnt vmcnt(1)
    v_xor_b32 v40, s56, v40
    v_xor_b32 v41, s57, v41
    v_xor_b32 v42, s58, v42
    v_xor_b32 v43, s59, v43
    v_or3_b32 v126, v40, v41, v42
    s_waitcnt vmcnt(0)
    v_xor_b32 v44, s56, v44
    v_xor_b32 v45, s57, v45
    v_xor_b32 v46, s58, v46
    v_xor_b32 v47, s59, v47
    v_or3_b32 v126, v126, v43, v44
    v_or3_b32 v127, v45, v46, v47
    v_bitop3_b32 v126, v126, v127, s4 bitop3:0xa8
    v_cmp_ne_u32 s[6:7], 0, v126
    s_mov_b64 exec, -1
    s_cmp_lg_u64 s[6:7], 0
    s_cbranch_scc1 L_omore
L_ogot:
    s_waitcnt lgkmcnt(0)
    v_readfirstlane_b32 s42, v9
L_ook:
    v_pk_mul_f32 v[52:53], v[40:41], v[48:49] op_sel_hi:[1,0]
    v_pk_mul_f32 v[54:55], v[42:43], v[48:49] op_sel_hi:[1,0]
    v_pk_fma_f32 v[52:53], v[44:45], v[48:49], v[52:53] op_sel:[0,1,0] op_sel_hi:[1,1,1]
    v_pk_fma_f32 v[54:55], v[46:47], v[48:49], v[54:55] op_sel:[0,1,0] op_sel_hi:[1,1,1]
    s_cmp_eq_u32 s42, 0
    s_cbranch_scc1 L_wmore
    v_lshlrev_b32 v119, 16, v118
    v_dot2_f32_bf16 v96, v88, v118, 0
    v_permlane32_swap_b32 v52, v54
    v_permlane32_swap_b32 v53, v55
    v_pk_add_f32 v[52:53], v[52:53], v[54:55]
    v_dot2_f32_bf16 v98, v89, v118, 0
    v_dot2_f32_bf16 v100, v90, v118, 0
    v_permlane16_swap_b32 v52, v53
    v_add_f32 v52, v52, v53
    v_dot2_f32_bf16 v102, v91, v118, 0
    v_dot2_f32_bf16 v97, v88, v119, 0
    v_add_f32_dpp v52, v52, v52 row_ror:8 row_mask:0xf bank_mask:0xf
    v_dot2_f32_bf16 v99, v89, v119, 0
    v_dot2_f32_bf16 v101, v90, v119, 0
    v_add_f32_dpp v52, v52, v52 row_ror:4 row_mask:0xf bank_mask:0xf
    v_cvt_pk_bf16_f32 v52, v52, v52
    ds_write_b16 v123, v52 offset:2304
    ds_read_b32 v116, v125 offset:2304
    v_dot2_f32_bf16 v103, v91, v119, 0
    v_permlane32_swap_b32 v96, v100
    v_permlane32_swap_b32 v97, v101
    v_permlane32_swap_b32 v98, v102
    v_permlane32_swap_b32 v99, v103
    v_pk_add_f32 v[96:97], v[96:97], v[100:101]
    v_pk_add_f32 v[98:99], v[98:99], v[102:103]
    s_nop 1
    v_permlane16_swap_b32 v96, v98
    v_permlane16_swap_b32 v97, v99
    v_pk_add_f32 v[96:97], v[96:97], v[98:99]
    s_nop 1
    v_add_f32_dpp v51, v96, v96 row_ror:8 row_mask:0xf bank_mask:0x3
    s_nop 1
    v_add_f32_dpp v51, v97, v97 row_ror:8 row_mask:0xf bank_mask:0xc
    s_waitcnt lgkmcnt(0)
    v_dot2_f32_bf16 v104, v16, v116, 0
    v_dot2_f32_bf16 v105, v17, v116, 0
    v_dot2_f32_bf16 v106, v18, v116, 0
    v_dot2_f32_bf16 v107, v19, v116, 0
    v_dot2_f32_bf16 v108, v20, v116, 0
    v_dot2_f32_bf16 v109, v21, v116, 0
    v_dot2_f32_bf16 v110, v22, v116, 0
    v_dot2_f32_bf16 v111, v23, v116, 0
    v_permlane32_swap_b32 v104, v108
    v_permlane32_swap_b32 v105, v109
    v_permlane32_swap_b32 v106, v110
    v_permlane32_swap_b32 v107, v111
    v_pk_add_f32 v[104:105], v[104:105], v[108:109]
    v_pk_add_f32 v[106:107], v[106:107], v[110:111]
    s_nop 1
    v_permlane16_swap_b32 v104, v106
    v_permlane16_swap_b32 v105, v107
    v_pk_add_f32 v[104:105], v[104:105], v[106:107]
    s_nop 1
    v_add_f32_dpp v50, v104, v104 row_ror:8 row_mask:0xf bank_mask:0x3
    s_nop 1
    v_add_f32_dpp v50, v105, v105 row_ror:8 row_mask:0xf bank_mask:0xc
    ds_write_b64 v2, v[50:51] offset:24576
    s_mov_b64 exec, 1
    ds_add_rtn_u32 v8, v72, v73 offset:1004
    s_mov_b64 exec, -1
    ds_read_b64 v[24:25], v75 offset:24576
    ds_read_b64 v[26:27], v75 offset:25088
    ds_read_b64 v[28:29], v75 offset:25600
    ds_read_b64 v[30:31], v75 offset:26112
    ds_read_b64 v[32:33], v75 offset:26624
    ds_read_b64 v[34:35], v75 offset:27136
    ds_read_b64 v[36:37], v75 offset:27648
    ds_read_b64 v[38:39], v75 offset:28160
    s_waitcnt lgkmcnt(6)
    v_readfirstlane_b32 s42, v8
    v_pk_add_f32 v[24:25], v[24:25], v[26:27]
    s_waitcnt lgkmcnt(4)
    v_pk_add_f32 v[28:29], v[28:29], v[30:31]
    s_cmp_lg_u32 s42, 7
    s_cbranch_scc1 L_wend
    v_pk_add_f32 v[24:25], v[24:25], v[28:29]
    s_waitcnt lgkmcnt(2)
    v_pk_add_f32 v[32:33], v[32:33], v[34:35]
    s_waitcnt lgkmcnt(0)
    v_pk_add_f32 v[36:37], v[36:37], v[38:39]
    v_pk_add_f32 v[32:33], v[32:33], v[36:37]
    v_pk_add_f32 v[24:25], v[24:25], v[32:33]
    v_perm_b32 v24, v24, s32, v120
    v_perm_b32 v25, v25, s32, v120
    s_nop 0
    v_mov_b32_dpp v12, v24 quad_perm:[0,0,0,0] row_mask:0xf bank_mask:0xf
    v_mov_b32_dpp v13, v24 quad_perm:[1,1,1,1] row_mask:0xf bank_mask:0xf
    v_mov_b32_dpp v14, v24 quad_perm:[2,2,2,2] row_mask:0xf bank_mask:0xf
    v_mov_b32_dpp v15, v24 quad_perm:[3,3,3,3] row_mask:0xf bank_mask:0xf
    v_cndmask_b32_dpp v12, v25, v12, vcc quad_perm:[0,0,0,0] row_mask:0xf bank_mask:0xf
    v_cndmask_b32_dpp v13, v25, v13, vcc quad_perm:[1,1,1,1] row_mask:0xf bank_mask:0xf
    v_cndmask_b32_dpp v14, v25, v14, vcc quad_perm:[2,2,2,2] row_mask:0xf bank_mask:0xf
    v_cndmask_b32_dpp v15, v25, v15, vcc quad_perm:[3,3,3,3] row_mask:0xf bank_mask:0xf
    s_mov_b64 exec, s[44:45]
    global_store_dwordx4 v122, v[12:15], s[26:27] sc1
L_wend:
    s_endpgm
L_w0:
    v_perm_b32 v40, v60, v56, s34
    v_perm_b32 v42, v60, v56, s35
    v_perm_b32 v44, v61, v57, s34
    v_perm_b32 v46, v61, v57, s35
    v_perm_b32 v48, v62, v58, s34
    v_perm_b32 v50, v62, v58, s35
    v_perm_b32 v52, v63, v59, s34
    v_perm_b32 v54, v63, v59, s35
    s_waitcnt vmcnt(0)
    s_branch L_wd
L_w2:
    v_perm_b32 v40, v60, v56, s34
    v_perm_b32 v42, v60, v56, s35
    v_perm_b32 v44, v61, v57, s34
    v_perm_b32 v46, v61, v57, s35
    v_perm_b32 v48, v62, v58, s34
    v_perm_b32 v50, v62, v58, s35
    v_perm_b32 v52, v63, v59, s34
    v_perm_b32 v54, v63, v59, s35
    s_waitcnt vmcnt(2)
    s_branch L_wd
L_omore:
    s_mov_b64 exec, s[6:7]
    global_load_dwordx4 v[40:43], v4, s[26:27] offset:0 sc1
    global_load_dwordx4 v[44:47], v4, s[26:27] offset:1024 sc1
    s_mov_b64 exec, -1
    ds_read_b32 v9, v72 offset:1000
    ds_read_b64 v[48:49], v74 offset:2176
    ds_read_u16 v118, v76 offset:2560
    s_mov_b64 exec, s[6:7]
    s_sub_u32 s41, s41, 1
    s_cbranch_scc0 L_ochk
    s_mov_b64 exec, -1
    s_waitcnt vmcnt(0)
L_wmore:
    ds_read_b32 v9, v72 offset:1000
    ds_read_b64 v[48:49], v74 offset:2176
    ds_read_u16 v118, v76 offset:2560
    s_branch L_ogot
L_comm:
    s_lshl_b32 s36, s28, 13
    s_add_u32 s36, s36, 16384
    s_lshl_b32 s37, s29, 8
    s_add_u32 s37, s37, s36
    v_and_b32 v81, 60, v1
    v_lshl_add_u32 v81, v81, 2, s37
    s_add_u32 s36, s36, 4096
    v_lshl_add_u32 v82, v1, 4, s36
    s_mov_b32 s34, 0x05040100
    s_mov_b32 s35, 0x07060302
    s_mov_b32 s60, 0x7060500
    s_mov_b32 s61, 0x7060501
    s_mov_b32 s62, 0x7060502
    s_mov_b32 s63, 0x7060503
    s_getreg_b32 s48, hwreg(HW_REG_XCC_ID, 0, 4)
    v_cmp_gt_u32 vcc, 56, v1
    s_nop 1
    v_cndmask_b32_e64 v108, 0, 1.0, vcc
    v_lshlrev_b32 v4, 1, v4
    s_mov_b32 s42, 0x3b124925
    v_and_b32 v120, 3, v1
    v_add_u32 v120, s60, v120
    s_waitcnt vmcnt(14)
    ds_write_b128 v2, v[8:11] offset:7168
    v_lshlrev_b32 v72, 16, v8
    v_and_b32 v73, 0xffff0000, v8
    v_lshlrev_b32 v74, 16, v9
    v_and_b32 v75, 0xffff0000, v9
    v_lshlrev_b32 v76, 16, v10
    v_and_b32 v77, 0xffff0000, v10
    v_lshlrev_b32 v78, 16, v11
    v_and_b32 v79, 0xffff0000, v11
    v_pk_add_f32 v[104:105], v[72:73], v[74:75]
    v_pk_add_f32 v[106:107], v[76:77], v[78:79]
    v_pk_add_f32 v[104:105], v[104:105], v[106:107]
    v_add_f32 v104, v104, v105
    v_mul_f32 v104, v104, v108
    s_nop 1
    v_add_f32_dpp v104, v104, v104 quad_perm:[1,0,3,2] row_mask:0xf bank_mask:0xf
    s_nop 1
    v_add_f32_dpp v104, v104, v104 quad_perm:[2,3,0,1] row_mask:0xf bank_mask:0xf
    s_nop 1
    v_add_f32_dpp v104, v104, v104 row_half_mirror row_mask:0xf bank_mask:0xf
    s_nop 1
    v_add_f32_dpp v104, v104, v104 row_mirror row_mask:0xf bank_mask:0xf
    v_mov_b32 v105, v104
    s_nop 1
    v_permlane16_swap_b32 v104, v105
    v_add_f32 v104, v104, v105
    v_mov_b32 v105, v104
    s_nop 1
    v_permlane32_swap_b32 v104, v105
    v_add_f32 v104, v104, v105
    v_mul_f32 v104, s42, v104
    v_sub_f32 v110, v72, v104
    v_sub_f32 v111, v73, v104
    v_sub_f32 v112, v74, v104
    v_sub_f32 v113, v75, v104
    v_sub_f32 v114, v76, v104
    v_sub_f32 v115, v77, v104
    v_sub_f32 v116, v78, v104
    v_sub_f32 v117, v79, v104
    v_mul_f32 v106, v110, v110
    v_mul_f32 v107, v111, v111
    v_fmac_f32 v106, v112, v112
    v_fmac_f32 v107, v113, v113
    v_fmac_f32 v106, v114, v114
    v_fmac_f32 v107, v115, v115
    v_fmac_f32 v106, v116, v116
    v_fmac_f32 v107, v117, v117
    v_cvt_pk_bf16_f32 v104, v104, v104
    v_and_b32 v104, 0xffff0000, v104
    v_add_f32 v106, v106, v107
    v_mul_f32 v106, v106, v108
    v_sub_f32 v72, v72, v104
    v_sub_f32 v73, v73, v104
    v_sub_f32 v74, v74, v104
    v_sub_f32 v75, v75, v104
    v_sub_f32 v76, v76, v104
    v_sub_f32 v77, v77, v104
    v_sub_f32 v78, v78, v104
    v_sub_f32 v79, v79, v104
    v_add_f32_dpp v106, v106, v106 quad_perm:[1,0,3,2] row_mask:0xf bank_mask:0xf
    s_nop 1
    v_add_f32_dpp v106, v106, v106 quad_perm:[2,3,0,1] row_mask:0xf bank_mask:0xf
    s_nop 1
    v_add_f32_dpp v106, v106, v106 row_half_mirror row_mask:0xf bank_mask:0xf
    s_nop 1
    v_add_f32_dpp v106, v106, v106 row_mirror row_mask:0xf bank_mask:0xf
    v_mov_b32 v107, v106
    s_nop 1
    v_permlane16_swap_b32 v106, v107
    v_add_f32 v106, v106, v107
    v_mov_b32 v107, v106
    s_nop 1
    v_permlane32_swap_b32 v106, v107
    v_add_f32 v106, v106, v107
    v_cvt_pk_bf16_f32 v8, v72, v73
    v_cvt_pk_bf16_f32 v9, v74, v75
    v_cvt_pk_bf16_f32 v10, v76, v77
    v_cvt_pk_bf16_f32 v11, v78, v79
    v_mul_f32 v106, s42, v106
    v_cvt_pk_bf16_f32 v106, v106, v106
    v_and_b32 v106, 0xffff0000, v106
    v_add_f32 v106, 0x3727c5ac, v106
    v_cvt_pk_bf16_f32 v106, v106, v106
    v_and_b32 v106, 0xffff0000, v106
    v_sqrt_f32 v106, v106
    v_lshlrev_b32 v72, 16, v8
    v_and_b32 v73, 0xffff0000, v8
    v_lshlrev_b32 v74, 16, v9
    v_and_b32 v75, 0xffff0000, v9
    v_lshlrev_b32 v76, 16, v10
    v_and_b32 v77, 0xffff0000, v10
    v_lshlrev_b32 v78, 16, v11
    v_and_b32 v79, 0xffff0000, v11
    v_cvt_pk_bf16_f32 v106, v106, v106
    v_and_b32 v106, 0xffff0000, v106
    v_rcp_f32 v106, v106
    s_nop 0
    v_mul_f32 v72, v72, v106
    v_mul_f32 v73, v73, v106
    v_mul_f32 v74, v74, v106
    v_mul_f32 v75, v75, v106
    v_mul_f32 v76, v76, v106
    v_mul_f32 v77, v77, v106
    v_mul_f32 v78, v78, v106
    v_mul_f32 v79, v79, v106
    v_cvt_pk_bf16_f32 v8, v72, v73
    v_cvt_pk_bf16_f32 v9, v74, v75
    v_cvt_pk_bf16_f32 v10, v76, v77
    v_cvt_pk_bf16_f32 v11, v78, v79
    ds_write_b128 v2, v[8:11] offset:0
    ds_write_b32 v6, v120 offset:984
    ds_read2_b32 v[86:87], v4 offset0:0 offset1:1
    ds_read2_b32 v[88:89], v4 offset0:2 offset1:3
    ds_read2_b32 v[90:91], v4 offset0:4 offset1:5
    ds_read_b32 v92, v4 offset:24
    s_waitcnt vmcnt(12)
    v_perm_b32 v72, v20, v16, s34
    v_perm_b32 v73, v20, v16, s35
    v_perm_b32 v74, v21, v17, s34
    v_perm_b32 v75, v21, v17, s35
    v_perm_b32 v76, v22, v18, s34
    v_perm_b32 v77, v22, v18, s35
    v_perm_b32 v78, v23, v19, s34
    v_perm_b32 v79, v23, v19, s35
    s_waitcnt lgkmcnt(0)
    s_add_u32 s32, s32, 2654435769
    s_bfe_u32 s56, s32, 0x80000
    s_bfe_u32 s57, s32, 0x80008
    s_bfe_u32 s58, s32, 0x80010
    s_bfe_u32 s59, s32, 0x80018
    s_lshl_b32 s40, s48, 24
    s_xor_b32 s40, s40, s32
    s_xor_b32 s48, s48, s59
    v_dot2_f32_bf16 v96, v72, v86, 0
    v_dot2_f32_bf16 v97, v73, v86, 0
    v_dot2_f32_bf16 v98, v74, v86, 0
    v_dot2_f32_bf16 v99, v75, v86, 0
    v_dot2_f32_bf16 v100, v76, v86, 0
    v_dot2_f32_bf16 v101, v77, v86, 0
    v_dot2_f32_bf16 v102, v78, v86, 0
    v_dot2_f32_bf16 v103, v79, v86, 0
    s_waitcnt vmcnt(10)
    v_perm_b32 v72, v28, v24, s34
    v_perm_b32 v73, v28, v24, s35
    v_perm_b32 v74, v29, v25, s34
    v_perm_b32 v75, v29, v25, s35
    v_perm_b32 v76, v30, v26, s34
    v_perm_b32 v77, v30, v26, s35
    v_perm_b32 v78, v31, v27, s34
    v_perm_b32 v79, v31, v27, s35
    v_dot2_f32_bf16 v96, v72, v87, v96
    v_dot2_f32_bf16 v97, v73, v87, v97
    v_dot2_f32_bf16 v98, v74, v87, v98
    v_dot2_f32_bf16 v99, v75, v87, v99
    v_dot2_f32_bf16 v100, v76, v87, v100
    v_dot2_f32_bf16 v101, v77, v87, v101
    v_dot2_f32_bf16 v102, v78, v87, v102
    v_dot2_f32_bf16 v103, v79, v87, v103
    s_waitcnt vmcnt(8)
    v_perm_b32 v72, v36, v32, s34
    v_perm_b32 v73, v36, v32, s35
    v_perm_b32 v74, v37, v33, s34
    v_perm_b32 v75, v37, v33, s35
    v_perm_b32 v76, v38, v34, s34
    v_perm_b32 v77, v38, v34, s35
    v_perm_b32 v78, v39, v35, s34
    v_perm_b32 v79, v39, v35, s35
    v_dot2_f32_bf16 v96, v72, v88, v96
    v_dot2_f32_bf16 v97, v73, v88, v97
    v_dot2_f32_bf16 v98, v74, v88, v98
    v_dot2_f32_bf16 v99, v75, v88, v99
    v_dot2_f32_bf16 v100, v76, v88, v100
    v_dot2_f32_bf16 v101, v77, v88, v101
    v_dot2_f32_bf16 v102, v78, v88, v102
    v_dot2_f32_bf16 v103, v79, v88, v103
    s_waitcnt vmcnt(6)
    v_perm_b32 v72, v44, v40, s34
    v_perm_b32 v73, v44, v40, s35
    v_perm_b32 v74, v45, v41, s34
    v_perm_b32 v75, v45, v41, s35
    v_perm_b32 v76, v46, v42, s34
    v_perm_b32 v77, v46, v42, s35
    v_perm_b32 v78, v47, v43, s34
    v_perm_b32 v79, v47, v43, s35
    v_dot2_f32_bf16 v96, v72, v89, v96
    v_dot2_f32_bf16 v97, v73, v89, v97
    v_dot2_f32_bf16 v98, v74, v89, v98
    v_dot2_f32_bf16 v99, v75, v89, v99
    v_dot2_f32_bf16 v100, v76, v89, v100
    v_dot2_f32_bf16 v101, v77, v89, v101
    v_dot2_f32_bf16 v102, v78, v89, v102
    v_dot2_f32_bf16 v103, v79, v89, v103
    s_waitcnt vmcnt(4)
    v_perm_b32 v72, v52, v48, s34
    v_perm_b32 v73, v52, v48, s35
    v_perm_b32 v74, v53, v49, s34
    v_perm_b32 v75, v53, v49, s35
    v_perm_b32 v76, v54, v50, s34
    v_perm_b32 v77, v54, v50, s35
    v_perm_b32 v78, v55, v51, s34
    v_perm_b32 v79, v55, v51, s35
    v_dot2_f32_bf16 v96, v72, v90, v96
    v_dot2_f32_bf16 v97, v73, v90, v97
    v_dot2_f32_bf16 v98, v74, v90, v98
    v_dot2_f32_bf16 v99, v75, v90, v99
    v_dot2_f32_bf16 v100, v76, v90, v100
    v_dot2_f32_bf16 v101, v77, v90, v101
    v_dot2_f32_bf16 v102, v78, v90, v102
    v_dot2_f32_bf16 v103, v79, v90, v103
    s_waitcnt vmcnt(2)
    v_perm_b32 v72, v60, v56, s34
    v_perm_b32 v73, v60, v56, s35
    v_perm_b32 v74, v61, v57, s34
    v_perm_b32 v75, v61, v57, s35
    v_perm_b32 v76, v62, v58, s34
    v_perm_b32 v77, v62, v58, s35
    v_perm_b32 v78, v63, v59, s34
    v_perm_b32 v79, v63, v59, s35
    v_dot2_f32_bf16 v96, v72, v91, v96
    v_dot2_f32_bf16 v97, v73, v91, v97
    v_dot2_f32_bf16 v98, v74, v91, v98
    v_dot2_f32_bf16 v99, v75, v91, v99
    v_dot2_f32_bf16 v100, v76, v91, v100
    v_dot2_f32_bf16 v101, v77, v91, v101
    v_dot2_f32_bf16 v102, v78, v91, v102
    v_dot2_f32_bf16 v103, v79, v91, v103
    s_waitcnt vmcnt(0)
    v_perm_b32 v72, v68, v64, s34
    v_perm_b32 v73, v68, v64, s35
    v_perm_b32 v74, v69, v65, s34
    v_perm_b32 v75, v69, v65, s35
    v_perm_b32 v76, v70, v66, s34
    v_perm_b32 v77, v70, v66, s35
    v_perm_b32 v78, v71, v67, s34
    v_perm_b32 v79, v71, v67, s35
    v_dot2_f32_bf16 v96, v72, v92, v96
    v_dot2_f32_bf16 v97, v73, v92, v97
    v_dot2_f32_bf16 v98, v74, v92, v98
    v_dot2_f32_bf16 v99, v75, v92, v99
    v_dot2_f32_bf16 v100, v76, v92, v100
    v_dot2_f32_bf16 v101, v77, v92, v101
    v_dot2_f32_bf16 v102, v78, v92, v102
    v_dot2_f32_bf16 v103, v79, v92, v103
    s_mov_b32 s50, 0x11111111
    s_mov_b32 s51, 0x11111111
    v_permlane32_swap_b32 v96, v100
    v_permlane32_swap_b32 v97, v101
    v_permlane32_swap_b32 v98, v102
    v_permlane32_swap_b32 v99, v103
    v_pk_add_f32 v[96:97], v[96:97], v[100:101]
    v_pk_add_f32 v[98:99], v[98:99], v[102:103]
    s_nop 1
    v_permlane16_swap_b32 v96, v98
    v_permlane16_swap_b32 v97, v99
    v_pk_add_f32 v[96:97], v[96:97], v[98:99]
    s_nop 1
    v_add_f32_dpp v98, v96, v96 row_ror:8 row_mask:0xf bank_mask:0x3
    s_nop 1
    v_add_f32_dpp v98, v97, v97 row_ror:8 row_mask:0xf bank_mask:0xc
    v_add_u32 v98, 0x80, v98
    v_perm_b32 v98, v98, s40, v120
    s_nop 1
    v_mov_b32_dpp v12, v98 quad_perm:[0,0,0,0] row_mask:0xf bank_mask:0xf
    v_mov_b32_dpp v13, v98 quad_perm:[1,1,1,1] row_mask:0xf bank_mask:0xf
    v_mov_b32_dpp v14, v98 quad_perm:[2,2,2,2] row_mask:0xf bank_mask:0xf
    v_mov_b32_dpp v15, v98 quad_perm:[3,3,3,3] row_mask:0xf bank_mask:0xf
    s_mov_b64 exec, s[50:51]
    global_store_dwordx4 v81, v[12:15], s[26:27]
    s_mov_b64 exec, -1
    v_and_b32 v7, 48, v1
    v_lshlrev_b32 v7, 3, v7
    v_and_b32 v9, 1, v1
    v_lshl_add_u32 v7, v9, 6, v7
    v_and_b32 v4, 14, v1
    v_add_u32 v7, v4, v7
    s_mov_b32 s33, 0x3db8aa3b
    s_mov_b32 s39, 0xff
    s_lshl_b32 s42, s28, 10
    s_lshl_b32 s43, s29, 4
    s_add_u32 s42, s42, s43
    s_add_u32 s42, s42, 4096
    v_lshlrev_b32 v9, 5, v9
    v_lshl_add_u32 v8, v9, 4, s42
    v_mov_b32 v11, s32
    s_waitcnt vmcnt(0)
    s_mov_b32 s46, 2
    s_mov_b32 s52, 0xff
    s_mov_b32 s41, 12
L_Q_poll:
    global_load_dwordx4 v[16:19], v82, s[26:27] offset:-4096 sc1
    global_load_dwordx4 v[20:23], v82, s[26:27] offset:-3072 sc1
    global_load_dwordx4 v[24:27], v82, s[26:27] offset:-2048 sc1
    global_load_dwordx4 v[28:31], v82, s[26:27] offset:-1024 sc1
    global_load_dwordx4 v[32:35], v82, s[26:27] offset:0 sc1
    global_load_dwordx4 v[36:39], v82, s[26:27] offset:1024 sc1
    global_load_dwordx4 v[40:43], v82, s[26:27] offset:2048 sc1
    global_load_dwordx4 v[44:47], v82, s[26:27] offset:3072 sc1
    s_waitcnt vmcnt(7)
    v_xor_b32 v16, s56, v16
    v_xor_b32 v17, s57, v17
    v_xor_b32 v18, s58, v18
    v_xor_b32 v19, s48, v19
    v_or3_b32 v126, v16, v17, v18
    v_mov_b32 v127, v19
    s_waitcnt vmcnt(6)
    v_xor_b32 v20, s56, v20
    v_xor_b32 v21, s57, v21
    v_xor_b32 v22, s58, v22
    v_xor_b32 v23, s48, v23
    v_or3_b32 v126, v126, v20, v21
    v_or_b32 v127, v127, v23
    v_or_b32 v126, v126, v22
    s_waitcnt vmcnt(5)
    v_xor_b32 v24, s56, v24
    v_xor_b32 v25, s57, v25
    v_xor_b32 v26, s58, v26
    v_xor_b32 v27, s48, v27
    v_or3_b32 v126, v126, v24, v25
    v_or_b32 v127, v127, v27
    v_or_b32 v126, v126, v26
    s_waitcnt vmcnt(4)
    v_xor_b32 v28, s56, v28
    v_xor_b32 v29, s57, v29
    v_xor_b32 v30, s58, v30
    v_xor_b32 v31, s48, v31
    v_or3_b32 v126, v126, v28, v29
    v_or_b32 v127, v127, v31
    v_or_b32 v126, v126, v30
    s_waitcnt vmcnt(3)
    v_xor_b32 v32, s56, v32
    v_xor_b32 v33, s57, v33
    v_xor_b32 v34, s58, v34
    v_xor_b32 v35, s48, v35
    v_or3_b32 v126, v126, v32, v33
    v_or_b32 v127, v127, v35
    v_or_b32 v126, v126, v34
    s_waitcnt vmcnt(2)
    v_xor_b32 v36, s56, v36
    v_xor_b32 v37, s57, v37
    v_xor_b32 v38, s58, v38
    v_xor_b32 v39, s48, v39
    v_or3_b32 v126, v126, v36, v37
    v_or_b32 v127, v127, v39
    v_or_b32 v126, v126, v38
    s_waitcnt vmcnt(1)
    v_xor_b32 v40, s56, v40
    v_xor_b32 v41, s57, v41
    v_xor_b32 v42, s58, v42
    v_xor_b32 v43, s48, v43
    v_or3_b32 v126, v126, v40, v41
    v_or_b32 v127, v127, v43
    v_or_b32 v126, v126, v42
    s_waitcnt vmcnt(0)
    v_xor_b32 v44, s56, v44
    v_xor_b32 v45, s57, v45
    v_xor_b32 v46, s58, v46
    v_xor_b32 v47, s48, v47
    v_or3_b32 v126, v126, v44, v45
    v_or_b32 v127, v127, v47
    v_or_b32 v126, v126, v46
    v_and_b32 v127, s52, v127
    v_and_b32 v126, 0xff, v126
    v_or_b32 v126, v126, v127
    v_cmp_ne_u32 vcc, 0, v126
    s_nop 0
    s_cmp_eq_u64 vcc, 0
    s_cbranch_scc1 L_Q_ok
    s_sub_u32 s41, s41, 1
    s_cbranch_scc0 L_Q_poll
    s_cmp_eq_u32 s46, 1
    s_cbranch_scc1 L_Q_ok
    s_mov_b32 s46, 1
    s_mov_b32 s52, 0xf0
    s_mov_b32 s41, 20000
    s_mov_b64 exec, s[50:51]
    global_store_dwordx4 v81, v[12:15], s[26:27] sc1
    s_mov_b64 exec, -1
    s_branch L_Q_poll
L_Q_ok:
    v_and_b32 v19, 0xffffff00, v19
    v_and_b32 v23, 0xffffff00, v23
    v_and_b32 v27, 0xffffff00, v27
    v_and_b32 v31, 0xffffff00, v31
    v_and_b32 v35, 0xffffff00, v35
    v_and_b32 v39, 0xffffff00, v39
    v_and_b32 v43, 0xffffff00, v43
    v_and_b32 v47, 0xffffff00, v47
    v_pk_add_f32 v[16:17], v[16:17], v[24:25]
    v_pk_add_f32 v[32:33], v[32:33], v[40:41]
    v_pk_add_f32 v[18:19], v[18:19], v[26:27]
    v_pk_add_f32 v[34:35], v[34:35], v[42:43]
    v_pk_add_f32 v[20:21], v[20:21], v[28:29]
    v_pk_add_f32 v[36:37], v[36:37], v[44:45]
    v_pk_add_f32 v[22:23], v[22:23], v[30:31]
    v_pk_add_f32 v[38:39], v[38:39], v[46:47]
    v_pk_add_f32 v[16:17], v[16:17], v[32:33]
    v_pk_add_f32 v[18:19], v[18:19], v[34:35]
    v_pk_add_f32 v[20:21], v[20:21], v[36:37]
    v_pk_add_f32 v[22:23], v[22:23], v[38:39]
    v_cvt_pk_bf16_f32 v16, v16, v17
    v_cvt_pk_bf16_f32 v18, v18, v19
    v_cvt_pk_bf16_f32 v20, v20, v21
    v_cvt_pk_bf16_f32 v22, v22, v23
    v_mov_b32 v10, s46
    ds_write_b16 v7, v16 offset:1024
    ds_write_b16_d16_hi v7, v16 offset:1040
    ds_write_b16 v7, v18 offset:1056
    ds_write_b16_d16_hi v7, v18 offset:1072
    ds_write_b16 v7, v20 offset:1536
    ds_write_b16_d16_hi v7, v20 offset:1552
    ds_write_b16 v7, v22 offset:1568
    ds_write_b16_d16_hi v7, v22 offset:1584
    ds_write_b32 v6, v10 offset:1008
    s_lshr_b32 s42, s29, 3
    s_and_b32 s43, s28, 1
    s_add_u32 s42, s42, s43
    s_cmp_ge_u32 s42, 4
    s_cbranch_scc1 L_gupub
    v_and_b32 v4, 31, v1
    v_lshlrev_b32 v4, 4, v4
    s_lshl_b32 s42, s28, 14
    s_lshl_b32 s43, s29, 9
    s_add_u32 s42, s42, s43
    s_add_u32 s42, s42, 98304
    v_add_u32 v5, s42, v4
L_gspin:
    ds_read_b32 v12, v6 offset:992
    ds_read_b128 v[48:51], v4 offset:3584
    ds_read_b128 v[52:55], v4 offset:4096
    ds_read_b128 v[56:59], v4 offset:4608
    ds_read_b128 v[60:63], v4 offset:5120
    ds_read_b128 v[64:67], v4 offset:5632
    ds_read_b128 v[68:71], v4 offset:6144
    ds_read_b128 v[72:75], v4 offset:6656
    s_waitcnt lgkmcnt(0)
    v_readfirstlane_b32 s42, v12
    s_nop 0
    s_cmp_lg_u32 s42, 7
    s_cbranch_scc1 L_gspin
    v_pk_add_f32 v[48:49], v[48:49], v[52:53]
    v_pk_add_f32 v[50:51], v[50:51], v[54:55]
    v_pk_add_f32 v[56:57], v[56:57], v[60:61]
    v_pk_add_f32 v[58:59], v[58:59], v[62:63]
    v_pk_add_f32 v[64:65], v[64:65], v[68:69]
    v_pk_add_f32 v[66:67], v[66:67], v[70:71]
    v_pk_add_f32 v[48:49], v[48:49], v[56:57]
    v_pk_add_f32 v[50:51], v[50:51], v[58:59]
    v_pk_add_f32 v[64:65], v[64:65], v[72:73]
    v_pk_add_f32 v[66:67], v[66:67], v[74:75]
    v_pk_add_f32 v[48:49], v[48:49], v[64:65]
    v_pk_add_f32 v[50:51], v[50:51], v[66:67]
    v_perm_b32 v76, v48, v11, s60
    v_perm_b32 v77, v49, v11, s61
    v_perm_b32 v78, v50, v11, s62
    v_perm_b32 v79, v51, v11, s63
    s_mov_b32 exec_hi, 0
    s_cmp_lg_u32 s46, 2
    s_cbranch_scc1 L_ps1
    global_store_dwordx4 v5, v[76:79], s[26:27]
    s_branch L_gupub
L_ps1:
    global_store_dwordx4 v5, v[76:79], s[26:27] sc1
L_gupub:
    s_mov_b64 exec, -1
    global_load_dword v127, v8, s[26:27] sc1
    s_lshl_b32 s42, s28, 5
    v_add_u32 v12, s42, v1
    v_mul_u32_u24 v12, 2432, v12
    s_lshl_b32 s42, s29, 6
    s_add_u32 s42, s42, 262144
    v_add_u32 v12, s42, v12
    s_min_u32 s43, s29, 27
    s_and_b32 s42, s43, 28
    v_and_b32 v13, 3, v1
    v_add_u32 v13, s42, v13
    v_mul_u32_u24 v13, 4480, v13
    s_and_b32 s43, s43, 3
    s_lshl_b32 s42, s28, 2
    s_add_u32 s42, s42, s43
    s_lshl_b32 s42, s42, 7
    s_add_u32 s42, s42, 917504
    v_add_u32 v13, s42, v13
    v_cmp_gt_u32 vcc, 32, v1
    s_nop 1
    v_cndmask_b32 v12, v13, v12, vcc
    s_mov_b32 exec_hi, 15
    global_load_dword v127, v12, s[26:27] sc1
    s_mov_b64 exec, -1
L_lspin:
    s_sleep 1
    ds_read_b32 v12, v6 offset:1016
    ds_read_b128 v[56:59], v9 offset:2112
    ds_read_b128 v[60:63], v9 offset:2128
    ds_read_b128 v[64:67], v9 offset:2048
    ds_read_b128 v[68:71], v9 offset:2064
    s_waitcnt lgkmcnt(0)
    v_readfirstlane_b32 s42, v12
    s_nop 0
    s_cmp_lg_u32 s42, 8
    s_cbranch_scc1 L_lspin
    v_max3_f32 v72, v64, v65, v66
    v_max3_f32 v72, v72, v67, v68
    v_max3_f32 v72, v72, v69, v70
    v_max_f32 v72, v72, v71
    v_sub_f32 v64, v64, v72
    v_sub_f32 v65, v65, v72
    v_sub_f32 v66, v66, v72
    v_sub_f32 v67, v67, v72
    v_sub_f32 v68, v68, v72
    v_sub_f32 v69, v69, v72
    v_sub_f32 v70, v70, v72
    v_sub_f32 v71, v71, v72
    v_mul_f32 v64, s33, v64
    v_mul_f32 v65, s33, v65
    v_mul_f32 v66, s33, v66
    v_mul_f32 v67, s33, v67
    v_mul_f32 v68, s33, v68
    v_mul_f32 v69, s33, v69
    v_mul_f32 v70, s33, v70
    v_mul_f32 v71, s33, v71
    v_exp_f32 v64, v64
    v_exp_f32 v65, v65
    v_exp_f32 v66, v66
    v_exp_f32 v67, v67
    v_exp_f32 v68, v68
    v_exp_f32 v69, v69
    v_exp_f32 v70, v70
    v_exp_f32 v71, v71
    v_pk_mul_f32 v[56:57], v[56:57], v[64:65]
    v_pk_mul_f32 v[58:59], v[58:59], v[66:67]
    v_pk_mul_f32 v[60:61], v[60:61], v[68:69]
    v_pk_mul_f32 v[62:63], v[62:63], v[70:71]
    v_pk_add_f32 v[56:57], v[56:57], v[60:61]
    v_pk_add_f32 v[58:59], v[58:59], v[62:63]
    v_pk_add_f32 v[56:57], v[56:57], v[58:59]
    v_add_f32 v56, v56, v57
    v_perm_b32 v12, v72, v11, s60
    v_perm_b32 v13, v56, v11, s61
    v_perm_b32 v14, v72, v11, s62
    v_perm_b32 v15, v56, v11, s63
    s_mov_b64 exec, 3
    s_cmp_lg_u32 s46, 2
    s_cbranch_scc1 L_ps2
    global_store_dwordx4 v8, v[12:15], s[26:27]
    s_branch L_sdone
L_ps2:
    global_store_dwordx4 v8, v[12:15], s[26:27] sc1
L_sdone:
    s_mov_b64 exec, -1
    s_cmp_ge_u32 s29, 28
    s_cbranch_scc1 L_cfin
    s_and_b32 s43, s29, 1
    s_lshl_b32 s42, s28, 1
    s_add_u32 s42, s42, s43
    s_lshl_b32 s42, s42, 9
    s_add_u32 s42, s42, 4096
    v_and_b32 v7, 60, v1
    v_lshl_add_u32 v83, v7, 2, s42
    v_lshlrev_b32 v7, 1, v7
    s_and_b32 s44, s29, 3
    s_and_b32 s43, s28, 1
    s_add_u32 s43, s43, s44
    s_cmp_lt_u32 s43, 4
    s_cselect_b32 s45, -1, 0
    s_min_u32 s44, s44, 2
    s_cmp_lg_u32 s45, 0
    s_cbranch_scc0 L_nob
    s_and_b32 s44, s29, 3
L_nob:
    s_lshl_b32 s42, s28, 14
    s_lshl_b32 s44, s44, 12
    s_add_u32 s42, s42, s44
    s_add_u32 s42, s42, 98304
    v_lshl_add_u32 v5, v1, 4, s42
    s_mov_b32 s41, 20000
    global_load_dwordx4 v[52:55], v83, s[26:27] offset:0 sc1
    global_load_dwordx4 v[56:59], v83, s[26:27] offset:256 sc1
    s_mov_b32 s41, 20000
L_G_poll:
    global_load_dwordx4 v[16:19], v5, s[26:27] offset:0 sc1
    global_load_dwordx4 v[20:23], v5, s[26:27] offset:1024 sc1
    global_load_dwordx4 v[24:27], v5, s[26:27] offset:2048 sc1
    global_load_dwordx4 v[28:31], v5, s[26:27] offset:3072 sc1
    s_waitcnt vmcnt(3)
    v_xor_b32 v16, s56, v16
    v_xor_b32 v17, s57, v17
    v_xor_b32 v18, s58, v18
    v_xor_b32 v19, s59, v19
    v_or_b32 v126, v16, v17
    v_or_b32 v127, v18, v19
    s_waitcnt vmcnt(2)
    v_xor_b32 v20, s56, v20
    v_xor_b32 v21, s57, v21
    v_xor_b32 v22, s58, v22
    v_xor_b32 v23, s59, v23
    v_or3_b32 v126, v126, v20, v21
    v_or3_b32 v127, v127, v22, v23
    v_pk_add_f32 v[36:37], v[16:17], v[20:21]
    v_pk_add_f32 v[38:39], v[18:19], v[22:23]
    s_waitcnt vmcnt(1)
    v_xor_b32 v24, s56, v24
    v_xor_b32 v25, s57, v25
    v_xor_b32 v26, s58, v26
    v_xor_b32 v27, s59, v27
    v_or3_b32 v126, v126, v24, v25
    v_or3_b32 v127, v127, v26, v27
    v_pk_add_f32 v[36:37], v[36:37], v[24:25]
    v_pk_add_f32 v[38:39], v[38:39], v[26:27]
    s_waitcnt vmcnt(0)
    v_xor_b32 v28, s56, v28
    v_xor_b32 v29, s57, v29
    v_xor_b32 v30, s58, v30
    v_xor_b32 v31, s59, v31
    v_or3_b32 v126, v126, v28, v29
    v_or3_b32 v127, v127, v30, v31
    v_bitop3_b32 v126, v126, v127, s39 bitop3:0xa8
    v_cmp_ne_u32 vcc, 0, v126
    v_pk_add_f32 v[36:37], v[36:37], v[28:29]
    v_pk_add_f32 v[38:39], v[38:39], v[30:31]
    s_cmp_eq_u64 vcc, 0
    s_cbranch_scc1 L_G_ok
    s_sub_u32 s41, s41, 1
    s_cbranch_scc0 L_G_poll
L_G_ok:
    s_mov_b32 s42, 0x3d372713
    s_mov_b32 s43, 0xc0135761
    v_permlane32_swap_b32 v36, v37
    v_permlane32_swap_b32 v38, v39
    v_add_f32 v36, v36, v37
    v_add_f32 v38, v38, v39
    v_and_b32 v4, 31, v1
    v_lshlrev_b32 v4, 2, v4
    v_lshrrev_b32 v5, 5, v1
    v_lshl_add_u32 v4, v5, 1, v4
    v_cvt_pk_bf16_f32 v36, v36, v36
    v_and_b32 v36, 0xffff0000, v36
    v_cvt_pk_bf16_f32 v38, v38, v38
    v_and_b32 v38, 0xffff0000, v38
    v_mul_f32 v37, v36, v36
    v_fma_f32 v37, v37, s42, 1.0
    v_mul_f32 v37, v37, v36
    v_mul_f32 v37, s43, v37
    v_exp_f32 v37, v37
    s_nop 0
    v_add_f32 v37, 1.0, v37
    v_rcp_f32 v37, v37
    s_nop 0
    v_mul_f32 v36, v36, v37
    v_cvt_pk_bf16_f32 v36, v36, v36
    v_and_b32 v36, 0xffff0000, v36
    v_mul_f32 v36, v36, v38
    v_cvt_pk_bf16_f32 v36, v36, v36
    v_and_b32 v36, s45, v36
    ds_write_b16 v4, v36 offset:2560
    s_mov_b32 s41, 20000
L_S_poll:
    global_load_dwordx4 v[60:63], v83, s[26:27] offset:0 sc1
    global_load_dwordx4 v[64:67], v83, s[26:27] offset:256 sc1
    s_waitcnt vmcnt(3)
    v_xor_b32 v52, s56, v52
    v_xor_b32 v53, s57, v53
    v_xor_b32 v54, s58, v54
    v_xor_b32 v55, s59, v55
    v_or_b32 v126, v52, v53
    v_or_b32 v127, v54, v55
    v_mov_b32 v32, v52
    v_mov_b32 v34, v53
    s_waitcnt vmcnt(2)
    v_xor_b32 v56, s56, v56
    v_xor_b32 v57, s57, v57
    v_xor_b32 v58, s58, v58
    v_xor_b32 v59, s59, v59
    v_or3_b32 v126, v126, v56, v57
    v_or3_b32 v127, v127, v58, v59
    v_bitop3_b32 v126, v126, v127, s39 bitop3:0xa8
    v_cmp_ne_u32 vcc, 0, v126
    v_mov_b32 v33, v56
    v_mov_b32 v35, v57
    s_cmp_eq_u64 vcc, 0
    s_cbranch_scc1 L_S_ok
    global_load_dwordx4 v[52:55], v83, s[26:27] offset:0 sc1
    global_load_dwordx4 v[56:59], v83, s[26:27] offset:256 sc1
    s_waitcnt vmcnt(3)
    v_xor_b32 v60, s56, v60
    v_xor_b32 v61, s57, v61
    v_xor_b32 v62, s58, v62
    v_xor_b32 v63, s59, v63
    v_or_b32 v126, v60, v61
    v_or_b32 v127, v62, v63
    v_mov_b32 v32, v60
    v_mov_b32 v34, v61
    s_waitcnt vmcnt(2)
    v_xor_b32 v64, s56, v64
    v_xor_b32 v65, s57, v65
    v_xor_b32 v66, s58, v66
    v_xor_b32 v67, s59, v67
    v_or3_b32 v126, v126, v64, v65
    v_or3_b32 v127, v127, v66, v67
    v_bitop3_b32 v126, v126, v127, s39 bitop3:0xa8
    v_cmp_ne_u32 vcc, 0, v126
    v_mov_b32 v33, v64
    v_mov_b32 v35, v65
    s_cmp_eq_u64 vcc, 0
    s_cbranch_scc1 L_S_ok
    s_sub_u32 s41, s41, 1
    s_cbranch_scc0 L_S_poll
L_S_ok:
    v_max_f32 v48, v32, v33
    s_nop 1
    v_max_f32_dpp v48, v48, v48 row_ror:4 row_mask:0xf bank_mask:0xf
    s_nop 1
    v_max_f32_dpp v48, v48, v48 row_ror:8 row_mask:0xf bank_mask:0xf
    v_mov_b32 v49, v48
    s_nop 1
    v_permlane16_swap_b32 v48, v49
    v_max_f32 v48, v48, v49
    v_mov_b32 v49, v48
    s_nop 1
    v_permlane32_swap_b32 v48, v49
    v_max_f32 v48, v48, v49
    v_sub_f32 v32, v32, v48
    v_sub_f32 v33, v33, v48
    v_mul_f32 v32, s33, v32
    v_mul_f32 v33, s33, v33
    v_exp_f32 v32, v32
    v_exp_f32 v33, v33
    v_mul_f32 v49, v32, v34
    v_fmac_f32 v49, v33, v35
    s_nop 1
    v_add_f32_dpp v49, v49, v49 row_ror:4 row_mask:0xf bank_mask:0xf
    s_nop 1
    v_add_f32_dpp v49, v49, v49 row_ror:8 row_mask:0xf bank_mask:0xf
    v_mov_b32 v50, v49
    s_nop 1
    v_permlane16_swap_b32 v49, v50
    v_add_f32 v49, v49, v50
    v_mov_b32 v50, v49
    s_nop 1
    v_permlane32_swap_b32 v49, v50
    v_add_f32 v49, v49, v50
    v_rcp_f32 v49, v49
    s_nop 0
    v_mul_f32 v32, v32, v49
    v_mul_f32 v33, v33, v49
    ds_write_b64 v7, v[32:33] offset:2176
    ds_write_b32 v6, v120 offset:1000
L_cend:
    s_endpgm
L_cfin:
    s_lshl_b32 s49, s28, 2
    s_add_u32 s49, s49, s29
    s_sub_u32 s49, s49, 28
    s_cmp_ge_u32 s49, 28
    s_cbranch_scc1 L_cend
    s_mul_i32 s42, s49, 4480
    s_add_u32 s42, s42, 917504
    v_lshl_add_u32 v5, v1, 4, s42
    s_lshr_b32 s43, s49, 2
    s_lshl_b32 s43, s43, 7
    s_and_b32 s42, s49, 3
    s_lshl_b32 s42, s42, 2
    s_add_u32 s42, s42, s43
    v_and_b32 v2, 50, v1
    v_lshl_add_u32 v2, v9, 1, v2
    v_add_u32 v2, s42, v2
    ds_read_u16 v3, v2 offset:7168
    s_mov_b32 s43, 0xbfb8aa3b
    s_mov_b32 s44, 0x000f000f
    s_mov_b32 s45, 0x000f000f
L_fspin:
    s_sleep 1
    ds_read_b32 v12, v6 offset:996
    s_waitcnt lgkmcnt(0)
    v_readfirstlane_b32 s42, v12
    s_nop 0
    s_cmp_lg_u32 s42, 2
    s_cbranch_scc1 L_fspin
    v_lshlrev_b32 v3, 16, v3
    s_mov_b32 s41, 20000
    global_load_dwordx4 v[16:19], v5, s[26:27] offset:0 sc1
    global_load_dwordx4 v[20:23], v5, s[26:27] offset:1024 sc1
    global_load_dwordx4 v[24:27], v5, s[26:27] offset:2048 sc1
    global_load_dwordx4 v[28:31], v5, s[26:27] offset:3072 sc1
    global_load_dwordx4 v[32:35], v5, s[26:27] offset:0 sc1
    global_load_dwordx4 v[36:39], v5, s[26:27] offset:1024 sc1
    global_load_dwordx4 v[40:43], v5, s[26:27] offset:2048 sc1
    global_load_dwordx4 v[44:47], v5, s[26:27] offset:3072 sc1
L_X_poll:
    global_load_dwordx4 v[56:59], v5, s[26:27] offset:0 sc1
    global_load_dwordx4 v[60:63], v5, s[26:27] offset:1024 sc1
    global_load_dwordx4 v[64:67], v5, s[26:27] offset:2048 sc1
    global_load_dwordx4 v[68:71], v5, s[26:27] offset:3072 sc1
    s_waitcnt vmcnt(11)
    v_xor_b32 v16, s56, v16
    v_xor_b32 v17, s57, v17
    v_xor_b32 v18, s58, v18
    v_xor_b32 v19, s59, v19
    v_or_b32 v126, v16, v17
    v_or_b32 v127, v18, v19
    s_waitcnt vmcnt(10)
    v_xor_b32 v20, s56, v20
    v_xor_b32 v21, s57, v21
    v_xor_b32 v22, s58, v22
    v_xor_b32 v23, s59, v23
    v_or3_b32 v126, v126, v20, v21
    v_or3_b32 v127, v127, v22, v23
    v_pk_add_f32 v[48:49], v[16:17], v[20:21]
    v_pk_add_f32 v[50:51], v[18:19], v[22:23]
    s_waitcnt vmcnt(9)
    v_xor_b32 v24, s56, v24
    v_xor_b32 v25, s57, v25
    v_xor_b32 v26, s58, v26
    v_xor_b32 v27, s59, v27
    v_or3_b32 v126, v126, v24, v25
    v_or3_b32 v127, v127, v26, v27
    v_pk_add_f32 v[48:49], v[48:49], v[24:25]
    v_pk_add_f32 v[50:51], v[50:51], v[26:27]
    s_waitcnt vmcnt(8)
    v_xor_b32 v28, s56, v28
    v_xor_b32 v29, s57, v29
    v_xor_b32 v30, s58, v30
    v_xor_b32 v31, s59, v31
    v_or3_b32 v126, v126, v28, v29
    v_or3_b32 v127, v127, v30, v31
    v_bitop3_b32 v126, v126, v127, s39 bitop3:0xa8
    v_cmp_ne_u32 vcc, 0, v126
    v_pk_add_f32 v[48:49], v[48:49], v[28:29]
    v_pk_add_f32 v[50:51], v[50:51], v[30:31]
    s_cmp_eq_u64 vcc, 0
    s_cbranch_scc1 L_X_ok
    global_load_dwordx4 v[16:19], v5, s[26:27] offset:0 sc1
    global_load_dwordx4 v[20:23], v5, s[26:27] offset:1024 sc1
    global_load_dwordx4 v[24:27], v5, s[26:27] offset:2048 sc1
    global_load_dwordx4 v[28:31], v5, s[26:27] offset:3072 sc1
    s_waitcnt vmcnt(11)
    v_xor_b32 v32, s56, v32
    v_xor_b32 v33, s57, v33
    v_xor_b32 v34, s58, v34
    v_xor_b32 v35, s59, v35
    v_or_b32 v126, v32, v33
    v_or_b32 v127, v34, v35
    s_waitcnt vmcnt(10)
    v_xor_b32 v36, s56, v36
    v_xor_b32 v37, s57, v37
    v_xor_b32 v38, s58, v38
    v_xor_b32 v39, s59, v39
    v_or3_b32 v126, v126, v36, v37
    v_or3_b32 v127, v127, v38, v39
    v_pk_add_f32 v[48:49], v[32:33], v[36:37]
    v_pk_add_f32 v[50:51], v[34:35], v[38:39]
    s_waitcnt vmcnt(9)
    v_xor_b32 v40, s56, v40
    v_xor_b32 v41, s57, v41
    v_xor_b32 v42, s58, v42
    v_xor_b32 v43, s59, v43
    v_or3_b32 v126, v126, v40, v41
    v_or3_b32 v127, v127, v42, v43
    v_pk_add_f32 v[48:49], v[48:49], v[40:41]
    v_pk_add_f32 v[50:51], v[50:51], v[42:43]
    s_waitcnt vmcnt(8)
    v_xor_b32 v44, s56, v44
    v_xor_b32 v45, s57, v45
    v_xor_b32 v46, s58, v46
    v_xor_b32 v47, s59, v47
    v_or3_b32 v126, v126, v44, v45
    v_or3_b32 v127, v127, v46, v47
    v_bitop3_b32 v126, v126, v127, s39 bitop3:0xa8
    v_cmp_ne_u32 vcc, 0, v126
    v_pk_add_f32 v[48:49], v[48:49], v[44:45]
    v_pk_add_f32 v[50:51], v[50:51], v[46:47]
    s_cmp_eq_u64 vcc, 0
    s_cbranch_scc1 L_X_ok
    global_load_dwordx4 v[32:35], v5, s[26:27] offset:0 sc1
    global_load_dwordx4 v[36:39], v5, s[26:27] offset:1024 sc1
    global_load_dwordx4 v[40:43], v5, s[26:27] offset:2048 sc1
    global_load_dwordx4 v[44:47], v5, s[26:27] offset:3072 sc1
    s_waitcnt vmcnt(11)
    v_xor_b32 v56, s56, v56
    v_xor_b32 v57, s57, v57
    v_xor_b32 v58, s58, v58
    v_xor_b32 v59, s59, v59
    v_or_b32 v126, v56, v57
    v_or_b32 v127, v58, v59
    s_waitcnt vmcnt(10)
    v_xor_b32 v60, s56, v60
    v_xor_b32 v61, s57, v61
    v_xor_b32 v62, s58, v62
    v_xor_b32 v63, s59, v63
    v_or3_b32 v126, v126, v60, v61
    v_or3_b32 v127, v127, v62, v63
    v_pk_add_f32 v[48:49], v[56:57], v[60:61]
    v_pk_add_f32 v[50:51], v[58:59], v[62:63]
    s_waitcnt vmcnt(9)
    v_xor_b32 v64, s56, v64
    v_xor_b32 v65, s57, v65
    v_xor_b32 v66, s58, v66
    v_xor_b32 v67, s59, v67
    v_or3_b32 v126, v126, v64, v65
    v_or3_b32 v127, v127, v66, v67
    v_pk_add_f32 v[48:49], v[48:49], v[64:65]
    v_pk_add_f32 v[50:51], v[50:51], v[66:67]
    s_waitcnt vmcnt(8)
    v_xor_b32 v68, s56, v68
    v_xor_b32 v69, s57, v69
    v_xor_b32 v70, s58, v70
    v_xor_b32 v71, s59, v71
    v_or3_b32 v126, v126, v68, v69
    v_or3_b32 v127, v127, v70, v71
    v_bitop3_b32 v126, v126, v127, s39 bitop3:0xa8
    v_cmp_ne_u32 vcc, 0, v126
    v_pk_add_f32 v[48:49], v[48:49], v[68:69]
    v_pk_add_f32 v[50:51], v[50:51], v[70:71]
    s_cmp_eq_u64 vcc, 0
    s_cbranch_scc1 L_X_ok
    s_sub_u32 s41, s41, 1
    s_cbranch_scc0 L_X_poll
L_X_ok:
    v_permlane32_swap_b32 v48, v50
    v_permlane32_swap_b32 v49, v51
    v_pk_add_f32 v[48:49], v[48:49], v[50:51]
    s_nop 1
    v_permlane16_swap_b32 v48, v49
    v_add_f32 v48, v48, v49
    s_nop 1
    v_add_f32_dpp v48, v48, v48 row_ror:8 row_mask:0xf bank_mask:0xf
    v_cvt_pk_bf16_f32 v48, v48, v48
    v_and_b32 v48, 0xffff0000, v48
    v_mul_f32 v49, s43, v48
    v_exp_f32 v49, v49
    s_nop 0
    v_add_f32 v49, 1.0, v49
    v_rcp_f32 v49, v49
    s_nop 0
    v_mul_f32 v49, v48, v49
    v_cvt_pk_bf16_f32 v49, v49, v49
    v_and_b32 v49, 0xffff0000, v49
    s_nop 1
    v_mul_f32_dpp v48, v49, v48 row_ror:4 row_mask:0xf bank_mask:0xf
    v_cvt_pk_bf16_f32 v48, v48, v48
    v_and_b32 v48, 0xffff0000, v48
    s_mov_b64 exec, s[44:45]
    v_add_f32 v48, v48, v3
    v_cvt_pk_bf16_f32 v48, v48, v48
    global_store_short v2, v48, s[22:23]
    s_cmp_lg_u32 s49, 0
    s_cbranch_scc1 L_cend
    s_mov_b64 exec, 1
    global_store_dword v6, v11, s[26:27]
    s_branch L_cend
L_end:
    s_endpgm
.section .rodata,"a"
.p2align 6
.amdhsa_kernel recurrent_scan__sliding_block_cached__geglu_ffn__decode_kernel
  .amdhsa_next_free_vgpr 128
  .amdhsa_next_free_sgpr 64
  .amdhsa_accum_offset 128
  .amdhsa_group_segment_fixed_size 0
  .amdhsa_kernarg_size 96
  .amdhsa_user_sgpr_count 2
  .amdhsa_user_sgpr_kernarg_segment_ptr 1
  .amdhsa_system_sgpr_workgroup_id_x 1
.end_amdhsa_kernel
```
